```python
import torch

def _softmax(x, axis=-1):
    return torch.softmax(x, dim=axis)
def _gelu(x):
    return torch.nn.functional.gelu(x, approximate="tanh")
def _silu(x):
    return torch.nn.functional.silu(x)
def _sigmoid(x):
    return torch.sigmoid(x)
def _layernorm(x, axis=-1, eps=1e-5):
    m = x.mean(dim=axis, keepdim=True)
    v = x.var(dim=axis, keepdim=True, unbiased=False)
    return (x - m) / torch.sqrt(v + eps)
def _scatter_add(tgt, idx, src, axis=0):
    return tgt.clone().index_add_(axis, idx, src)
def _segment_sum(src, seg, n):
    out = torch.zeros((n,) + src.shape[1:], dtype=src.dtype)
    return out.index_add_(0, seg, src)
def _pad(x, pw):
    flat = tuple(v for pair in reversed(pw) for v in pair)
    return torch.nn.functional.pad(x, flat)

kernel_name = 'standalone__grn__sampling'

def setup_inputs():

    _w = (lambda a: (lambda t: t.to(torch.bfloat16) if t.is_floating_point() else t)(torch.as_tensor(a)))
    B, S, D = 1024, 32, 576
    return {
        "x": _w((lambda *s: torch.randn(*s, dtype=torch.bfloat16) * 0.05)(B, S, D)),
        "g": _w((lambda *s: torch.randn(*s, dtype=torch.bfloat16) * 0.4)(D) * 0.1),
        "b": _w((lambda *s: torch.randn(*s, dtype=torch.bfloat16) * 0.1)(D) * 0.1),
    }

def reference(x, g, b):
    gx = torch.sqrt((x * x).sum(axis=-2, keepdims=True))
    nx = gx / (gx.mean(axis=-1, keepdims=True) + 1e-6)
    return g * (x * nx) + b + x
```

```asm
; @launch grid=(256,1,1) block=(768,1,1) lds=128
.amdgcn_target "amdgcn-amd-amdhsa--gfx950"
.text
.globl standalone__grn__sampling_kernel
.p2align 8
.type standalone__grn__sampling_kernel,@function
standalone__grn__sampling_kernel:
    s_load_dwordx2 s[4:5], s[0:1], 0
    s_load_dwordx2 s[12:13], s[0:1], 8
    s_load_dwordx2 s[16:17], s[0:1], 16
    s_load_dwordx2 s[8:9], s[0:1], 24
    s_cmp_ge_u32 s2, 256
    s_cbranch_scc1 L_end
    v_readfirstlane_b32 s25, v0
    s_lshr_b32 s25, s25, 6
    s_cmp_lg_u32 s25, 4
    s_cbranch_scc1 L_noz
    v_and_b32 v7, 15, v0
    v_lshlrev_b32 v7, 3, v7
    v_mov_b32 v158, 0
    v_mov_b32 v159, 0
    ds_write_b64 v7, v[158:159]
    s_waitcnt lgkmcnt(0)
L_noz:
    v_and_b32 v6, 7, v0
    v_bfe_u32 v5, v0, 3, 3
    v_lshlrev_b32 v2, 4, v6
    s_mul_i32 s27, s25, 43
    v_mul_u32_u24 v1, 1152, v5
    s_lshr_b32 s27, s27, 7
    v_add_u32 v1, v1, v2
    s_mul_i32 s26, s27, 3
    v_lshl_add_u32 v3, v5, 1, v2
    s_sub_u32 s26, s25, s26
    s_cmp_lg_u32 s25, 0
    s_cbranch_scc1 L_nopf
    s_getpc_b64 s[32:33]
L_pc:
    v_lshlrev_b32 v0, 7, v0
    v_min_u32 v0, L_end-L_pc, v0
    global_load_dword v0, v0, s[32:33]
L_nopf:
    s_cmp_lt_u32 s25, 4
    s_cbranch_scc1 L_ib1
    s_barrier
L_ib1:
    s_and_b32 s20, s2, 7
    s_lshl_b32 s20, s20, 7
    s_lshr_b32 s31, s2, 3
    s_add_u32 s20, s20, s31
    s_lshl_b32 s31, s27, 5
    s_add_u32 s20, s20, s31
    s_mul_i32 s20, s20, 36864
    s_mul_i32 s24, s26, 384
    s_mov_b32 s6, 37748736
    s_add_u32 s20, s20, s24
    s_mov_b32 s7, 0x20000
    s_add_u32 s21, s20, 9216
    s_add_u32 s22, s20, 18432
    s_add_u32 s23, s20, 27648
    s_mov_b32 s14, 1152
    s_mov_b32 s15, 0x20000
    s_mov_b32 s18, 1152
    s_mov_b32 s19, 0x20000
    s_waitcnt lgkmcnt(0)
    buffer_load_dwordx4 v[12:15], v1, s[4:7], s20 offen offset:0 nt
    buffer_load_dwordx4 v[20:23], v1, s[4:7], s21 offen offset:0 nt
    buffer_load_dwordx4 v[28:31], v1, s[4:7], s22 offen offset:0 nt
    buffer_load_dwordx4 v[36:39], v1, s[4:7], s23 offen offset:0 nt
    buffer_load_ushort v152, v3, s[12:15], s24 offen offset:0
    buffer_load_ushort v153, v3, s[12:15], s24 offen offset:128
    buffer_load_ushort v154, v3, s[12:15], s24 offen offset:256
    buffer_load_dwordx4 v[132:135], v2, s[16:19], s24 offen offset:0
    buffer_load_dwordx4 v[140:143], v2, s[16:19], s24 offen offset:128
    buffer_load_dwordx4 v[148:151], v2, s[16:19], s24 offen offset:256
    buffer_load_dwordx4 v[44:47], v1, s[4:7], s20 offen offset:128 nt
    buffer_load_dwordx4 v[52:55], v1, s[4:7], s21 offen offset:128 nt
    buffer_load_dwordx4 v[60:63], v1, s[4:7], s22 offen offset:128 nt
    buffer_load_dwordx4 v[68:71], v1, s[4:7], s23 offen offset:128 nt
    buffer_load_dwordx4 v[76:79], v1, s[4:7], s20 offen offset:256 nt
    buffer_load_dwordx4 v[84:87], v1, s[4:7], s21 offen offset:256 nt
    buffer_load_dwordx4 v[92:95], v1, s[4:7], s22 offen offset:256 nt
    buffer_load_dwordx4 v[100:103], v1, s[4:7], s23 offen offset:256 nt
    s_cmp_ge_u32 s25, 4
    s_cbranch_scc1 L_ib2
    s_barrier
L_ib2:
    s_mov_b32 s10, 37748736
    s_mov_b32 s11, 0x20000
    s_mov_b32 s30, 0xffff0000
    s_lshl_b32 s40, s27, 5
    s_lshl_b32 s41, s26, 2
    s_add_u32 s41, s41, s40
    v_mov_b32 v7, s41
    v_mov_b32 v5, s40
    v_mov_b32 v159, 1
    s_getreg_b32 s42, hwreg(HW_REG_XCC_ID)
    s_and_b32 s42, s42, 1
    s_cmp_ge_u32 s27, 2
    s_cselect_b32 s43, 1, 0
    s_and_b32 s34, s42, s43
    s_andn2_b32 s35, s43, s42
    s_cmp_eq_u32 s34, 0
    s_cbranch_scc1 L_g0
    s_barrier
L_g0:
    s_waitcnt vmcnt(17)
    v_lshlrev_b32 v8, 16, v12
    v_and_b32 v9, s30, v12
    v_lshlrev_b32 v10, 16, v13
    v_and_b32 v11, s30, v13
    v_lshlrev_b32 v12, 16, v14
    v_and_b32 v13, s30, v14
    v_lshlrev_b32 v14, 16, v15
    v_and_b32 v15, s30, v15
    v_pk_mul_f32 v[104:105], v[8:9], v[8:9]
    v_pk_mul_f32 v[106:107], v[10:11], v[10:11]
    v_pk_mul_f32 v[108:109], v[12:13], v[12:13]
    v_pk_mul_f32 v[110:111], v[14:15], v[14:15]
    s_waitcnt vmcnt(16)
    v_lshlrev_b32 v16, 16, v20
    v_and_b32 v17, s30, v20
    v_lshlrev_b32 v18, 16, v21
    v_and_b32 v19, s30, v21
    v_lshlrev_b32 v20, 16, v22
    v_and_b32 v21, s30, v22
    v_lshlrev_b32 v22, 16, v23
    v_and_b32 v23, s30, v23
    v_pk_fma_f32 v[104:105], v[16:17], v[16:17], v[104:105]
    v_pk_fma_f32 v[106:107], v[18:19], v[18:19], v[106:107]
    v_pk_fma_f32 v[108:109], v[20:21], v[20:21], v[108:109]
    v_pk_fma_f32 v[110:111], v[22:23], v[22:23], v[110:111]
    s_waitcnt vmcnt(15)
    v_lshlrev_b32 v24, 16, v28
    v_and_b32 v25, s30, v28
    v_lshlrev_b32 v26, 16, v29
    v_and_b32 v27, s30, v29
    v_lshlrev_b32 v28, 16, v30
    v_and_b32 v29, s30, v30
    v_lshlrev_b32 v30, 16, v31
    v_and_b32 v31, s30, v31
    v_pk_fma_f32 v[104:105], v[24:25], v[24:25], v[104:105]
    v_pk_fma_f32 v[106:107], v[26:27], v[26:27], v[106:107]
    v_pk_fma_f32 v[108:109], v[28:29], v[28:29], v[108:109]
    v_pk_fma_f32 v[110:111], v[30:31], v[30:31], v[110:111]
    s_waitcnt vmcnt(14)
    v_lshlrev_b32 v32, 16, v36
    v_and_b32 v33, s30, v36
    v_lshlrev_b32 v34, 16, v37
    v_and_b32 v35, s30, v37
    v_lshlrev_b32 v36, 16, v38
    v_and_b32 v37, s30, v38
    v_lshlrev_b32 v38, 16, v39
    v_and_b32 v39, s30, v39
    v_pk_fma_f32 v[104:105], v[32:33], v[32:33], v[104:105]
    v_pk_fma_f32 v[106:107], v[34:35], v[34:35], v[106:107]
    v_pk_fma_f32 v[108:109], v[36:37], v[36:37], v[108:109]
    v_pk_fma_f32 v[110:111], v[38:39], v[38:39], v[110:111]
    s_nop 0
    v_permlane32_swap_b32 v104, v108
    v_permlane32_swap_b32 v105, v109
    v_permlane32_swap_b32 v106, v110
    v_permlane32_swap_b32 v107, v111
    v_add_f32 v104, v104, v108
    v_add_f32 v105, v105, v109
    v_add_f32 v106, v106, v110
    v_add_f32 v107, v107, v111
    s_nop 0
    v_permlane16_swap_b32 v104, v106
    v_permlane16_swap_b32 v105, v107
    v_add_f32 v104, v104, v106
    v_add_f32 v105, v105, v107
    s_nop 0
    v_add_f32_dpp v106, v104, v104 row_ror:8 row_mask:0xf bank_mask:0x3
    s_nop 1
    v_add_f32_dpp v106, v105, v105 row_ror:8 row_mask:0xf bank_mask:0xc
    v_sqrt_f32 v104, v106
    s_nop 0
    v_mov_b32 v158, v104
    s_waitcnt vmcnt(8)
    v_lshlrev_b32 v128, 16, v132
    v_and_b32 v129, s30, v132
    v_lshlrev_b32 v130, 16, v133
    v_and_b32 v131, s30, v133
    v_lshlrev_b32 v132, 16, v134
    v_and_b32 v133, s30, v134
    v_lshlrev_b32 v134, 16, v135
    v_and_b32 v135, s30, v135
    v_lshlrev_b32 v136, 16, v140
    v_and_b32 v137, s30, v140
    v_lshlrev_b32 v138, 16, v141
    v_and_b32 v139, s30, v141
    v_lshlrev_b32 v140, 16, v142
    v_and_b32 v141, s30, v142
    v_lshlrev_b32 v142, 16, v143
    v_and_b32 v143, s30, v143
    v_lshlrev_b32 v144, 16, v148
    v_and_b32 v145, s30, v148
    v_lshlrev_b32 v146, 16, v149
    v_and_b32 v147, s30, v149
    v_lshlrev_b32 v148, 16, v150
    v_and_b32 v149, s30, v150
    v_lshlrev_b32 v150, 16, v151
    v_and_b32 v151, s30, v151
    v_lshlrev_b32 v152, 16, v152
    v_mul_f32 v105, v152, v104
    v_mov_b32 v104, v105
    s_nop 1
    v_mov_b32_dpp v104, v104 row_ror:8 row_mask:0xf bank_mask:0xc
    v_mov_b32_dpp v105, v105 row_ror:8 row_mask:0xf bank_mask:0x3
    v_mov_b32 v106, v104
    v_mov_b32 v107, v105
    s_nop 0
    v_permlane16_swap_b32 v104, v106
    v_permlane16_swap_b32 v105, v107
    v_mov_b32 v108, v104
    v_mov_b32 v109, v105
    v_mov_b32 v110, v106
    v_mov_b32 v111, v107
    v_permlane32_swap_b32 v104, v108
    v_permlane32_swap_b32 v105, v109
    v_permlane32_swap_b32 v106, v110
    v_permlane32_swap_b32 v107, v111
    s_waitcnt vmcnt(7)
    v_lshlrev_b32 v40, 16, v44
    v_and_b32 v41, s30, v44
    v_lshlrev_b32 v42, 16, v45
    v_and_b32 v43, s30, v45
    v_lshlrev_b32 v44, 16, v46
    v_and_b32 v45, s30, v46
    v_lshlrev_b32 v46, 16, v47
    v_and_b32 v47, s30, v47
    v_pk_mul_f32 v[112:113], v[40:41], v[40:41]
    v_pk_mul_f32 v[114:115], v[42:43], v[42:43]
    v_pk_mul_f32 v[116:117], v[44:45], v[44:45]
    v_pk_mul_f32 v[118:119], v[46:47], v[46:47]
    s_waitcnt vmcnt(6)
    v_lshlrev_b32 v48, 16, v52
    v_and_b32 v49, s30, v52
    v_lshlrev_b32 v50, 16, v53
    v_and_b32 v51, s30, v53
    v_lshlrev_b32 v52, 16, v54
    v_and_b32 v53, s30, v54
    v_lshlrev_b32 v54, 16, v55
    v_and_b32 v55, s30, v55
    v_pk_fma_f32 v[112:113], v[48:49], v[48:49], v[112:113]
    v_pk_fma_f32 v[114:115], v[50:51], v[50:51], v[114:115]
    v_pk_fma_f32 v[116:117], v[52:53], v[52:53], v[116:117]
    v_pk_fma_f32 v[118:119], v[54:55], v[54:55], v[118:119]
    s_waitcnt vmcnt(5)
    v_lshlrev_b32 v56, 16, v60
    v_and_b32 v57, s30, v60
    v_lshlrev_b32 v58, 16, v61
    v_and_b32 v59, s30, v61
    v_lshlrev_b32 v60, 16, v62
    v_and_b32 v61, s30, v62
    v_lshlrev_b32 v62, 16, v63
    v_and_b32 v63, s30, v63
    v_pk_fma_f32 v[112:113], v[56:57], v[56:57], v[112:113]
    v_pk_fma_f32 v[114:115], v[58:59], v[58:59], v[114:115]
    v_pk_fma_f32 v[116:117], v[60:61], v[60:61], v[116:117]
    v_pk_fma_f32 v[118:119], v[62:63], v[62:63], v[118:119]
    s_waitcnt vmcnt(4)
    s_cmp_eq_u32 s35, 0
    s_cbranch_scc1 L_g1
    s_barrier
L_g1:
    v_lshlrev_b32 v64, 16, v68
    v_and_b32 v65, s30, v68
    v_lshlrev_b32 v66, 16, v69
    v_and_b32 v67, s30, v69
    v_lshlrev_b32 v68, 16, v70
    v_and_b32 v69, s30, v70
    v_lshlrev_b32 v70, 16, v71
    v_and_b32 v71, s30, v71
    v_pk_fma_f32 v[112:113], v[64:65], v[64:65], v[112:113]
    v_pk_fma_f32 v[114:115], v[66:67], v[66:67], v[114:115]
    v_pk_fma_f32 v[116:117], v[68:69], v[68:69], v[116:117]
    v_pk_fma_f32 v[118:119], v[70:71], v[70:71], v[118:119]
    s_nop 0
    v_permlane32_swap_b32 v112, v116
    v_permlane32_swap_b32 v113, v117
    v_permlane32_swap_b32 v114, v118
    v_permlane32_swap_b32 v115, v119
    v_add_f32 v112, v112, v116
    v_add_f32 v113, v113, v117
    v_add_f32 v114, v114, v118
    v_add_f32 v115, v115, v119
    s_nop 0
    v_permlane16_swap_b32 v112, v114
    v_permlane16_swap_b32 v113, v115
    v_add_f32 v112, v112, v114
    v_add_f32 v113, v113, v115
    s_nop 0
    v_add_f32_dpp v114, v112, v112 row_ror:8 row_mask:0xf bank_mask:0x3
    s_nop 1
    v_add_f32_dpp v114, v113, v113 row_ror:8 row_mask:0xf bank_mask:0xc
    v_sqrt_f32 v112, v114
    s_nop 0
    v_add_f32 v158, v158, v112
    v_lshlrev_b32 v153, 16, v153
    v_mul_f32 v113, v153, v112
    v_mov_b32 v112, v113
    s_nop 1
    v_mov_b32_dpp v112, v112 row_ror:8 row_mask:0xf bank_mask:0xc
    v_mov_b32_dpp v113, v113 row_ror:8 row_mask:0xf bank_mask:0x3
    v_mov_b32 v114, v112
    v_mov_b32 v115, v113
    s_nop 0
    v_permlane16_swap_b32 v112, v114
    v_permlane16_swap_b32 v113, v115
    v_mov_b32 v116, v112
    v_mov_b32 v117, v113
    v_mov_b32 v118, v114
    v_mov_b32 v119, v115
    v_permlane32_swap_b32 v112, v116
    v_permlane32_swap_b32 v113, v117
    v_permlane32_swap_b32 v114, v118
    v_permlane32_swap_b32 v115, v119
    s_waitcnt vmcnt(3)
    v_lshlrev_b32 v72, 16, v76
    v_and_b32 v73, s30, v76
    v_lshlrev_b32 v74, 16, v77
    v_and_b32 v75, s30, v77
    v_lshlrev_b32 v76, 16, v78
    v_and_b32 v77, s30, v78
    v_lshlrev_b32 v78, 16, v79
    v_and_b32 v79, s30, v79
    v_pk_mul_f32 v[120:121], v[72:73], v[72:73]
    v_pk_mul_f32 v[122:123], v[74:75], v[74:75]
    v_pk_mul_f32 v[124:125], v[76:77], v[76:77]
    v_pk_mul_f32 v[126:127], v[78:79], v[78:79]
    s_waitcnt vmcnt(2)
    v_lshlrev_b32 v80, 16, v84
    v_and_b32 v81, s30, v84
    v_lshlrev_b32 v82, 16, v85
    v_and_b32 v83, s30, v85
    v_lshlrev_b32 v84, 16, v86
    v_and_b32 v85, s30, v86
    v_lshlrev_b32 v86, 16, v87
    v_and_b32 v87, s30, v87
    v_pk_fma_f32 v[120:121], v[80:81], v[80:81], v[120:121]
    v_pk_fma_f32 v[122:123], v[82:83], v[82:83], v[122:123]
    v_pk_fma_f32 v[124:125], v[84:85], v[84:85], v[124:125]
    v_pk_fma_f32 v[126:127], v[86:87], v[86:87], v[126:127]
    s_waitcnt vmcnt(1)
    v_lshlrev_b32 v88, 16, v92
    v_and_b32 v89, s30, v92
    v_lshlrev_b32 v90, 16, v93
    v_and_b32 v91, s30, v93
    v_lshlrev_b32 v92, 16, v94
    v_and_b32 v93, s30, v94
    v_lshlrev_b32 v94, 16, v95
    v_and_b32 v95, s30, v95
    v_pk_fma_f32 v[120:121], v[88:89], v[88:89], v[120:121]
    v_pk_fma_f32 v[122:123], v[90:91], v[90:91], v[122:123]
    v_pk_fma_f32 v[124:125], v[92:93], v[92:93], v[124:125]
    v_pk_fma_f32 v[126:127], v[94:95], v[94:95], v[126:127]
    s_waitcnt vmcnt(0)
    v_lshlrev_b32 v96, 16, v100
    v_and_b32 v97, s30, v100
    v_lshlrev_b32 v98, 16, v101
    v_and_b32 v99, s30, v101
    v_lshlrev_b32 v100, 16, v102
    v_and_b32 v101, s30, v102
    v_lshlrev_b32 v102, 16, v103
    v_and_b32 v103, s30, v103
    v_pk_fma_f32 v[120:121], v[96:97], v[96:97], v[120:121]
    v_pk_fma_f32 v[122:123], v[98:99], v[98:99], v[122:123]
    v_pk_fma_f32 v[124:125], v[100:101], v[100:101], v[124:125]
    v_pk_fma_f32 v[126:127], v[102:103], v[102:103], v[126:127]
    s_nop 0
    v_permlane32_swap_b32 v120, v124
    v_permlane32_swap_b32 v121, v125
    v_permlane32_swap_b32 v122, v126
    v_permlane32_swap_b32 v123, v127
    v_add_f32 v120, v120, v124
    v_add_f32 v121, v121, v125
    v_add_f32 v122, v122, v126
    v_add_f32 v123, v123, v127
    s_nop 0
    v_permlane16_swap_b32 v120, v122
    v_permlane16_swap_b32 v121, v123
    v_add_f32 v120, v120, v122
    v_add_f32 v121, v121, v123
    s_nop 0
    v_add_f32_dpp v122, v120, v120 row_ror:8 row_mask:0xf bank_mask:0x3
    s_nop 1
    v_add_f32_dpp v122, v121, v121 row_ror:8 row_mask:0xf bank_mask:0xc
    v_sqrt_f32 v120, v122
    s_nop 0
    v_add_f32 v158, v158, v120
    s_nop 1
    v_add_f32_dpp v158, v158, v158 row_ror:8 row_mask:0xf bank_mask:0xf
    s_nop 1
    v_add_f32_dpp v158, v158, v158 row_ror:4 row_mask:0xf bank_mask:0xf
    s_nop 1
    v_add_f32_dpp v158, v158, v158 row_ror:2 row_mask:0xf bank_mask:0xf
    s_nop 1
    v_add_f32_dpp v158, v158, v158 row_ror:1 row_mask:0xf bank_mask:0xf
    s_nop 1
    v_add_f32_dpp v158, v158, v158 row_bcast:15 row_mask:0xa bank_mask:0xf
    s_nop 1
    v_add_f32_dpp v158, v158, v158 row_bcast:31 row_mask:0xc bank_mask:0xf
    s_mov_b32 exec_lo, 0
    s_mov_b32 exec_hi, 0x80000000
    ds_write_b32 v7, v158 offset:16
    ds_write_b32 v7, v159
    s_mov_b64 exec, -1
    v_lshlrev_b32 v154, 16, v154
    v_mul_f32 v121, v154, v120
    v_mov_b32 v120, v121
    s_nop 1
    v_mov_b32_dpp v120, v120 row_ror:8 row_mask:0xf bank_mask:0xc
    v_mov_b32_dpp v121, v121 row_ror:8 row_mask:0xf bank_mask:0x3
    v_mov_b32 v122, v120
    v_mov_b32 v123, v121
    s_nop 0
    v_permlane16_swap_b32 v120, v122
    v_permlane16_swap_b32 v121, v123
    v_mov_b32 v124, v120
    v_mov_b32 v125, v121
    v_mov_b32 v126, v122
    v_mov_b32 v127, v123
    v_permlane32_swap_b32 v120, v124
    v_permlane32_swap_b32 v121, v125
    v_permlane32_swap_b32 v122, v126
    v_permlane32_swap_b32 v123, v127
L_poll:
    ds_read_b96 v[160:162], v5
    ds_read_b96 v[164:166], v5 offset:16
    s_waitcnt lgkmcnt(0)
    v_and_b32 v4, v160, v161
    v_and_b32 v4, v4, v162
    v_cmp_eq_u32 vcc, 0, v4
    s_cbranch_vccnz L_poll
    v_add_f32 v4, v164, v165
    v_add_f32 v4, v4, v166
    v_mul_f32 v4, 0x3ae38e39, v4
    v_add_f32 v4, 0x358637bd, v4
    v_rcp_f32 v156, v4
    s_nop 0
    v_pk_fma_f32 v[104:105], v[104:105], v[156:157], 1.0 op_sel_hi:[1,0,0]
    v_pk_fma_f32 v[106:107], v[106:107], v[156:157], 1.0 op_sel_hi:[1,0,0]
    v_pk_fma_f32 v[108:109], v[108:109], v[156:157], 1.0 op_sel_hi:[1,0,0]
    v_pk_fma_f32 v[110:111], v[110:111], v[156:157], 1.0 op_sel_hi:[1,0,0]
    v_pk_fma_f32 v[112:113], v[112:113], v[156:157], 1.0 op_sel_hi:[1,0,0]
    v_pk_fma_f32 v[114:115], v[114:115], v[156:157], 1.0 op_sel_hi:[1,0,0]
    v_pk_fma_f32 v[116:117], v[116:117], v[156:157], 1.0 op_sel_hi:[1,0,0]
    v_pk_fma_f32 v[118:119], v[118:119], v[156:157], 1.0 op_sel_hi:[1,0,0]
    v_pk_fma_f32 v[120:121], v[120:121], v[156:157], 1.0 op_sel_hi:[1,0,0]
    v_pk_fma_f32 v[122:123], v[122:123], v[156:157], 1.0 op_sel_hi:[1,0,0]
    v_pk_fma_f32 v[124:125], v[124:125], v[156:157], 1.0 op_sel_hi:[1,0,0]
    v_pk_fma_f32 v[126:127], v[126:127], v[156:157], 1.0 op_sel_hi:[1,0,0]
    s_cmp_lg_u32 s43, 0
    s_cbranch_scc1 L_g2
    s_barrier
L_g2:
    v_pk_fma_f32 v[8:9], v[8:9], v[104:105], v[128:129]
    v_pk_fma_f32 v[10:11], v[10:11], v[106:107], v[130:131]
    v_pk_fma_f32 v[12:13], v[12:13], v[108:109], v[132:133]
    v_pk_fma_f32 v[14:15], v[14:15], v[110:111], v[134:135]
    v_cvt_pk_bf16_f32 v8, v8, v9
    v_cvt_pk_bf16_f32 v9, v10, v11
    v_cvt_pk_bf16_f32 v10, v12, v13
    v_cvt_pk_bf16_f32 v11, v14, v15
    buffer_store_dwordx4 v[8:11], v1, s[8:11], s20 offen offset:0 sc1
    v_pk_fma_f32 v[40:41], v[40:41], v[112:113], v[136:137]
    v_pk_fma_f32 v[42:43], v[42:43], v[114:115], v[138:139]
    v_pk_fma_f32 v[44:45], v[44:45], v[116:117], v[140:141]
    v_pk_fma_f32 v[46:47], v[46:47], v[118:119], v[142:143]
    v_cvt_pk_bf16_f32 v40, v40, v41
    v_cvt_pk_bf16_f32 v41, v42, v43
    v_cvt_pk_bf16_f32 v42, v44, v45
    v_cvt_pk_bf16_f32 v43, v46, v47
    buffer_store_dwordx4 v[40:43], v1, s[8:11], s20 offen offset:128 sc1
    v_pk_fma_f32 v[72:73], v[72:73], v[120:121], v[144:145]
    v_pk_fma_f32 v[74:75], v[74:75], v[122:123], v[146:147]
    v_pk_fma_f32 v[76:77], v[76:77], v[124:125], v[148:149]
    v_pk_fma_f32 v[78:79], v[78:79], v[126:127], v[150:151]
    v_cvt_pk_bf16_f32 v72, v72, v73
    v_cvt_pk_bf16_f32 v73, v74, v75
    v_cvt_pk_bf16_f32 v74, v76, v77
    v_cvt_pk_bf16_f32 v75, v78, v79
    buffer_store_dwordx4 v[72:75], v1, s[8:11], s20 offen offset:256 sc1
    v_pk_fma_f32 v[16:17], v[16:17], v[104:105], v[128:129]
    v_pk_fma_f32 v[18:19], v[18:19], v[106:107], v[130:131]
    v_pk_fma_f32 v[20:21], v[20:21], v[108:109], v[132:133]
    v_pk_fma_f32 v[22:23], v[22:23], v[110:111], v[134:135]
    v_cvt_pk_bf16_f32 v16, v16, v17
    v_cvt_pk_bf16_f32 v17, v18, v19
    v_cvt_pk_bf16_f32 v18, v20, v21
    v_cvt_pk_bf16_f32 v19, v22, v23
    buffer_store_dwordx4 v[16:19], v1, s[8:11], s21 offen offset:0 sc1
    v_pk_fma_f32 v[48:49], v[48:49], v[112:113], v[136:137]
    v_pk_fma_f32 v[50:51], v[50:51], v[114:115], v[138:139]
    v_pk_fma_f32 v[52:53], v[52:53], v[116:117], v[140:141]
    v_pk_fma_f32 v[54:55], v[54:55], v[118:119], v[142:143]
    v_cvt_pk_bf16_f32 v48, v48, v49
    v_cvt_pk_bf16_f32 v49, v50, v51
    v_cvt_pk_bf16_f32 v50, v52, v53
    v_cvt_pk_bf16_f32 v51, v54, v55
    buffer_store_dwordx4 v[48:51], v1, s[8:11], s21 offen offset:128 sc1
    v_pk_fma_f32 v[80:81], v[80:81], v[120:121], v[144:145]
    v_pk_fma_f32 v[82:83], v[82:83], v[122:123], v[146:147]
    v_pk_fma_f32 v[84:85], v[84:85], v[124:125], v[148:149]
    v_pk_fma_f32 v[86:87], v[86:87], v[126:127], v[150:151]
    v_cvt_pk_bf16_f32 v80, v80, v81
    v_cvt_pk_bf16_f32 v81, v82, v83
    v_cvt_pk_bf16_f32 v82, v84, v85
    v_cvt_pk_bf16_f32 v83, v86, v87
    buffer_store_dwordx4 v[80:83], v1, s[8:11], s21 offen offset:256 sc1
    v_pk_fma_f32 v[24:25], v[24:25], v[104:105], v[128:129]
    v_pk_fma_f32 v[26:27], v[26:27], v[106:107], v[130:131]
    v_pk_fma_f32 v[28:29], v[28:29], v[108:109], v[132:133]
    v_pk_fma_f32 v[30:31], v[30:31], v[110:111], v[134:135]
    v_cvt_pk_bf16_f32 v24, v24, v25
    v_cvt_pk_bf16_f32 v25, v26, v27
    v_cvt_pk_bf16_f32 v26, v28, v29
    v_cvt_pk_bf16_f32 v27, v30, v31
    buffer_store_dwordx4 v[24:27], v1, s[8:11], s22 offen offset:0 sc1
    v_pk_fma_f32 v[56:57], v[56:57], v[112:113], v[136:137]
    v_pk_fma_f32 v[58:59], v[58:59], v[114:115], v[138:139]
    v_pk_fma_f32 v[60:61], v[60:61], v[116:117], v[140:141]
    v_pk_fma_f32 v[62:63], v[62:63], v[118:119], v[142:143]
    v_cvt_pk_bf16_f32 v56, v56, v57
    v_cvt_pk_bf16_f32 v57, v58, v59
    v_cvt_pk_bf16_f32 v58, v60, v61
    v_cvt_pk_bf16_f32 v59, v62, v63
    buffer_store_dwordx4 v[56:59], v1, s[8:11], s22 offen offset:128 sc1
    v_pk_fma_f32 v[88:89], v[88:89], v[120:121], v[144:145]
    v_pk_fma_f32 v[90:91], v[90:91], v[122:123], v[146:147]
    v_pk_fma_f32 v[92:93], v[92:93], v[124:125], v[148:149]
    v_pk_fma_f32 v[94:95], v[94:95], v[126:127], v[150:151]
    v_cvt_pk_bf16_f32 v88, v88, v89
    v_cvt_pk_bf16_f32 v89, v90, v91
    v_cvt_pk_bf16_f32 v90, v92, v93
    v_cvt_pk_bf16_f32 v91, v94, v95
    buffer_store_dwordx4 v[88:91], v1, s[8:11], s22 offen offset:256 sc1
    v_pk_fma_f32 v[32:33], v[32:33], v[104:105], v[128:129]
    v_pk_fma_f32 v[34:35], v[34:35], v[106:107], v[130:131]
    v_pk_fma_f32 v[36:37], v[36:37], v[108:109], v[132:133]
    v_pk_fma_f32 v[38:39], v[38:39], v[110:111], v[134:135]
    v_cvt_pk_bf16_f32 v32, v32, v33
    v_cvt_pk_bf16_f32 v33, v34, v35
    v_cvt_pk_bf16_f32 v34, v36, v37
    v_cvt_pk_bf16_f32 v35, v38, v39
    buffer_store_dwordx4 v[32:35], v1, s[8:11], s23 offen offset:0 sc1
    v_pk_fma_f32 v[64:65], v[64:65], v[112:113], v[136:137]
    v_pk_fma_f32 v[66:67], v[66:67], v[114:115], v[138:139]
    v_pk_fma_f32 v[68:69], v[68:69], v[116:117], v[140:141]
    v_pk_fma_f32 v[70:71], v[70:71], v[118:119], v[142:143]
    v_cvt_pk_bf16_f32 v64, v64, v65
    v_cvt_pk_bf16_f32 v65, v66, v67
    v_cvt_pk_bf16_f32 v66, v68, v69
    v_cvt_pk_bf16_f32 v67, v70, v71
    buffer_store_dwordx4 v[64:67], v1, s[8:11], s23 offen offset:128 sc1
    v_pk_fma_f32 v[96:97], v[96:97], v[120:121], v[144:145]
    v_pk_fma_f32 v[98:99], v[98:99], v[122:123], v[146:147]
    v_pk_fma_f32 v[100:101], v[100:101], v[124:125], v[148:149]
    v_pk_fma_f32 v[102:103], v[102:103], v[126:127], v[150:151]
    v_cvt_pk_bf16_f32 v96, v96, v97
    v_cvt_pk_bf16_f32 v97, v98, v99
    v_cvt_pk_bf16_f32 v98, v100, v101
    v_cvt_pk_bf16_f32 v99, v102, v103
    buffer_store_dwordx4 v[96:99], v1, s[8:11], s23 offen offset:256 sc1
L_end:
    s_endpgm
.section .rodata,"a"
.p2align 6
.amdhsa_kernel standalone__grn__sampling_kernel
  .amdhsa_next_free_vgpr 167
  .amdhsa_next_free_sgpr 48
  .amdhsa_accum_offset 168
  .amdhsa_group_segment_fixed_size 0
  .amdhsa_kernarg_size 48
  .amdhsa_user_sgpr_count 2
  .amdhsa_user_sgpr_kernarg_segment_ptr 1
  .amdhsa_system_sgpr_workgroup_id_x 1
  .amdhsa_float_denorm_mode_32 3
.end_amdhsa_kernel
```
